```python
import torch

def _softmax(x, axis=-1):
    return torch.softmax(x, dim=axis)
def _gelu(x):
    return torch.nn.functional.gelu(x, approximate="tanh")
def _silu(x):
    return torch.nn.functional.silu(x)
def _sigmoid(x):
    return torch.sigmoid(x)
def _layernorm(x, axis=-1, eps=1e-5):
    m = x.mean(dim=axis, keepdim=True)
    v = x.var(dim=axis, keepdim=True, unbiased=False)
    return (x - m) / torch.sqrt(v + eps)
def _scatter_add(tgt, idx, src, axis=0):
    return tgt.clone().index_add_(axis, idx, src)
def _segment_sum(src, seg, n):
    out = torch.zeros((n,) + src.shape[1:], dtype=src.dtype)
    return out.index_add_(0, seg, src)
def _pad(x, pw):
    flat = tuple(v for pair in reversed(pw) for v in pair)
    return torch.nn.functional.pad(x, flat)

kernel_name = 'standalone__gqa_softmax__sampling'

def setup_inputs():

    _w = (lambda a: (lambda t: t.to(torch.bfloat16) if t.is_floating_point() else t)(torch.as_tensor(a)))
    B, Hq, Hkv, Sq, Sk, D = 8, 32, 32, 16, 2048, 128
    return {
        "q": _w((lambda *s: torch.randn(*s, dtype=torch.bfloat16) * 0.8)(B, Hq, Sq, D)),
        "k": _w((lambda *s: torch.randn(*s, dtype=torch.bfloat16) * 0.8)(B, Hkv, Sk, D)),
        "v": _w((lambda *s: torch.randn(*s, dtype=torch.bfloat16) * 0.05)(B, Hkv, Sk, D)),
    }

def reference(q, k, v):
    B, Hq, Sq, D = q.shape
    Hkv = k.shape[1]
    rep = Hq // Hkv
    k = (lambda x, n, axis: torch.repeat_interleave(x, n, dim=axis))(k, rep, axis=1)
    v = (lambda x, n, axis: torch.repeat_interleave(x, n, dim=axis))(v, rep, axis=1)
    scale = D ** -0.5
    scores = torch.einsum("bhqd,bhkd->bhqk", q, k) * scale
    p = _softmax(scores, axis=-1)
    return torch.einsum("bhqk,bhkd->bhqd", p, v)
```

```asm
; @launch grid=(256,1,1) block=(256,1,1) lds=143872
.amdgcn_target "amdgcn-amd-amdhsa--gfx950"
.text
.globl standalone__gqa_softmax__sampling_kernel
.p2align 12
.fill 832, 4, 0xbf810000
.p2align 8
.type standalone__gqa_softmax__sampling_kernel,@function
standalone__gqa_softmax__sampling_kernel:
    s_cmpk_ge_u32 s2, 0x100
    s_cbranch_scc1 L_end
    s_load_dwordx8 s[4:11], s[0:1], 0
    v_readfirstlane_b32 s33, v0
    v_and_b32 v1, 63, v0
    v_lshrrev_b32 v2, 4, v1
    v_lshlrev_b32 v26, 1, v2
    v_xor_b32 v26, v26, v1
    v_lshlrev_b32 v27, 4, v26
    v_mul_u32_u24 v26, 7936, v2
    v_add_u32 v4, v26, v27
    v_xor_b32 v5, 0x80, v4
    v_add_u32 v5, 64512, v5
    v_xor_b32 v6, 16, v4
    v_add_u32 v6, 30720, v6
    v_xor_b32 v7, 16, v5
    v_add_u32 v7, 30720, v7
    s_lshr_b32 s33, s33, 6
    s_and_b32 s35, s2, 0x7f
    s_mul_i32 s35, s35, 0x810000
    s_and_b32 s35, s35, 0x3f80000
    s_lshr_b32 s34, s2, 7
    s_lshl_b32 s36, s34, 18
    s_lshl_b32 s34, s34, 26
    s_or_b32 s35, s35, s34
    s_mul_i32 s34, s33, 0x500
    s_and_b32 s34, s34, 0x900
    s_or_b32 s36, s36, s34
    s_mov_b32 s46, s36
    s_lshl_b32 s19, s33, 14
    s_addk_i32 s19, 4096
    s_mul_i32 s34, s33, 0x88
    s_and_b32 s34, s34, 0x90
    v_xor_b32 v27, s34, v27
    s_lshl_b32 s32, s33, 10
    s_lshr_b32 s3, s35, 7
    s_lshl_b32 s14, 1, 19
    s_mov_b32 s15, 0x20000
    s_movk_i32 s22, 0x1000
    s_mov_b32 s23, s15
    s_mov_b32 m0, s32
    s_waitcnt lgkmcnt(0)
    s_add_u32 s20, s4, s3
    s_addc_u32 s21, s5, 0
    s_add_u32 s12, s6, s35
    buffer_load_dwordx4 v27, s[20:23], s32 offen lds
    s_mov_b32 m0, s19
    s_addc_u32 s13, s7, 0
    buffer_load_dwordx4 v4, s[12:15], s46 offen nt lds
    buffer_load_dwordx4 v5, s[12:15], s46 offen offset:1024 nt lds
    buffer_load_dwordx4 v6, s[12:15], s46 offen offset:2048 nt lds
    buffer_load_dwordx4 v7, s[12:15], s46 offen offset:3072 nt lds
    s_addk_i32 m0, 0x1000
    s_addk_i32 s46, 4096
    buffer_load_dwordx4 v4, s[12:15], s46 offen nt lds
    buffer_load_dwordx4 v5, s[12:15], s46 offen offset:1024 nt lds
    s_load_dwordx2 s[28:29], s[0:1], 40
    s_add_u32 s16, s8, s35
    s_addc_u32 s17, s9, 0
    s_add_u32 s24, s10, s3
    s_addc_u32 s25, s11, 0
    s_mov_b64 s[26:27], s[22:23]
    s_mov_b32 s37, 0
    s_mov_b32 s48, 394240
    s_movk_i32 s49, 2304
    v_and_b32 v3, 15, v0
    v_and_b32 v26, 7, v3
    v_xor_b32 v26, v26, v2
    v_lshrrev_b32 v27, 3, v3
    v_lshl_add_u32 v26, v26, 1, v27
    v_lshlrev_b32 v26, 4, v26
    v_lshl_add_u32 v10, v3, 8, v26
    v_xor_b32 v11, 16, v10
    v_xor_b32 v12, 0x80, v10
    v_xor_b32 v13, 16, v12
    s_mul_i32 s50, s33, 18432
    s_add_u32 s50, s50, 69632
    v_lshl_add_u32 v56, v1, 4, s50
    v_lshl_add_u32 v57, v1, 2, s50
    v_lshrrev_b32 v26, 2, v1
    v_and_b32 v27, 31, v1
    v_lshl_add_u32 v27, v26, 5, v27
    v_and_b32 v26, 2, v2
    v_xor_b32 v27, v26, v27
    v_lshl_add_u32 v14, v27, 3, s19
    v_xor_b32 v18, 0x80, v14
    v_xor_b32 v15, 32, v14
    v_xor_b32 v16, 64, v14
    v_xor_b32 v17, 64, v15
    v_xor_b32 v19, 32, v18
    v_xor_b32 v20, 64, v18
    v_xor_b32 v21, 64, v19
    s_lshl_b32 s34, s33, 7
    s_add_u32 s34, s34, 143360
    v_lshl_add_u32 v59, v3, 3, s34
    v_mov_b64 v[60:61], 0
    v_mov_b64 v[62:63], 0
    v_mov_b32 v44, 0x3f803f80
    v_mov_b32 v45, v44
    v_mov_b64 v[46:47], v[44:45]
    ds_write_b64 v59, v[60:61]
    v_mfma_f32_32x32x16_bf16 v[64:79], v[60:63], v[60:63], 0
    v_mfma_f32_32x32x16_bf16 v[80:95], v[60:63], v[60:63], 0
    v_mov_b32 v22, 0xff800000
    s_mov_b32 s32, 0x3e0293ee
    s_lshr_b32 s34, s2, 3
    v_lshl_add_u32 v58, v0, 8, s34
    s_and_b32 s34, s2, 7
    s_lshl_b32 s34, s34, 12
    s_movk_i32 s30, 128
    v_lshlrev_b32 v9, 2, v1
    s_getreg_b32 s3, hwreg(HW_REG_XCC_ID, 0, 1)
    s_mul_i32 s3, s3, 5
    s_add_u32 s3, s3, 25
    s_mov_b32 s31, s15
    s_mov_b32 s38, 64
    v_mov_b32 v8, 0
    s_mov_b64 vcc, 0
    s_waitcnt vmcnt(6) lgkmcnt(0)
    s_barrier
    ds_read_b128 v[28:31], v10
    ds_read_b128 v[32:35], v11
    ds_read_b128 v[36:39], v12
    ds_read_b128 v[40:43], v13
    s_add_u32 s28, s28, s34
    s_addc_u32 s29, s29, 0
    buffer_store_dword v8, v9, s[28:31], 0 offen
    v_add_u32 v10, s19, v10
    v_add_u32 v11, s19, v11
    v_add_u32 v12, s19, v12
    v_add_u32 v13, s19, v13
    s_waitcnt vmcnt(5)
    buffer_load_dwordx4 v6, s[12:15], s46 offen offset:2048 nt lds
    s_waitcnt vmcnt(5)
    buffer_load_dwordx4 v7, s[12:15], s46 offen offset:3072 nt lds
    s_addk_i32 m0, 0x1000
    s_addk_i32 s46, -3584
    s_waitcnt vmcnt(5)
    buffer_load_dwordx4 v4, s[12:15], s46 offen nt lds
    s_waitcnt vmcnt(5)
    buffer_load_dwordx4 v5, s[12:15], s46 offen offset:1024 nt lds
    s_waitcnt vmcnt(5)
    buffer_load_dwordx4 v6, s[12:15], s46 offen offset:2048 nt lds
L_k:
    s_waitcnt vmcnt(5)
    s_cbranch_vccnz L_hik0
    s_waitcnt vmcnt(4)
L_hik0:
    buffer_load_dwordx4 v7, s[12:15], s46 offen offset:3072 nt lds
    v_add_u32 v8, 1, v8
    buffer_store_byte v8, v58, s[28:31], 0 offen
    buffer_load_ubyte v9, v1, s[28:31], 0 offen nt
    ds_read_b128 v[96:99], v10 offset:0
    ds_read_b128 v[100:103], v11 offset:0
    ds_read_b128 v[104:107], v12 offset:0
    ds_read_b128 v[108:111], v13 offset:0
    s_addk_i32 m0, 0x1000
    s_addk_i32 s46, 4096
    s_waitcnt vmcnt(7)
    s_cbranch_vccnz L_hik1
    s_waitcnt vmcnt(6)
L_hik1:
    buffer_load_dwordx4 v4, s[12:15], s46 offen nt lds
    s_waitcnt lgkmcnt(0)
    v_mfma_f32_16x16x32_bf16 v[152:155], v[96:99], v[28:31], 0
    v_mfma_f32_16x16x32_bf16 v[152:155], v[100:103], v[32:35], v[152:155]
    v_mfma_f32_16x16x32_bf16 v[152:155], v[104:107], v[36:39], v[152:155]
    v_mfma_f32_16x16x32_bf16 v[152:155], v[108:111], v[40:43], v[152:155]
    s_waitcnt vmcnt(7)
    s_cbranch_vccnz L_hik2
    s_waitcnt vmcnt(6)
L_hik2:
    buffer_load_dwordx4 v5, s[12:15], s46 offen offset:1024 nt lds
    s_waitcnt vmcnt(7)
    s_cbranch_vccnz L_hik3
    s_waitcnt vmcnt(6)
L_hik3:
    buffer_load_dwordx4 v6, s[12:15], s46 offen offset:2048 nt lds
    s_waitcnt vmcnt(7)
    s_cbranch_vccnz L_hik4
    s_waitcnt vmcnt(6)
L_hik4:
    buffer_load_dwordx4 v7, s[12:15], s46 offen offset:3072 nt lds
    ds_read_b128 v[96:99], v10 offset:4096
    ds_read_b128 v[100:103], v11 offset:4096
    ds_read_b128 v[104:107], v12 offset:4096
    ds_read_b128 v[108:111], v13 offset:4096
    v_max_f32 v26, v152, v153
    v_max3_f32 v26, v154, v155, v26
    s_sub_u32 s37, s37, s48
    s_and_b32 s37, s37, s48
    s_cselect_b64 s[12:13], s[12:13], s[16:17]
    s_xor_b32 s46, s37, s36
    s_mov_b32 m0, s19
    s_waitcnt vmcnt(7)
    s_cbranch_vccnz L_hik5
    s_waitcnt vmcnt(6)
L_hik5:
    buffer_load_dwordx4 v4, s[12:15], s46 offen nt lds
    s_waitcnt lgkmcnt(0)
    v_mfma_f32_16x16x32_bf16 v[156:159], v[96:99], v[28:31], 0
    v_mfma_f32_16x16x32_bf16 v[156:159], v[100:103], v[32:35], v[156:159]
    v_mfma_f32_16x16x32_bf16 v[156:159], v[104:107], v[36:39], v[156:159]
    v_mfma_f32_16x16x32_bf16 v[156:159], v[108:111], v[40:43], v[156:159]
    s_waitcnt vmcnt(7)
    s_cbranch_vccnz L_hik6
    s_waitcnt vmcnt(4)
L_hik6:
    buffer_load_dwordx4 v5, s[12:15], s46 offen offset:1024 nt lds
    s_waitcnt vmcnt(5)
    s_cbranch_vccnz L_hik7
    s_waitcnt vmcnt(4)
L_hik7:
    buffer_load_dwordx4 v6, s[12:15], s46 offen offset:2048 nt lds
    v_cmp_le_u32 vcc, v8, v9
    s_bcnt1_i32_b64 s39, vcc
    s_cmp_ge_u32 s39, s38
    s_mov_b32 s38, s3
    s_cselect_b64 vcc, -1, 0
    s_waitcnt vmcnt(5)
    s_cbranch_vccnz L_hik8
    s_waitcnt vmcnt(4)
L_hik8:
    buffer_load_dwordx4 v7, s[12:15], s46 offen offset:3072 nt lds
    ds_read_b128 v[96:99], v10 offset:8192
    ds_read_b128 v[100:103], v11 offset:8192
    ds_read_b128 v[104:107], v12 offset:8192
    ds_read_b128 v[108:111], v13 offset:8192
    v_max3_f32 v26, v156, v157, v26
    v_max3_f32 v26, v158, v159, v26
    s_addk_i32 m0, 0x1000
    s_addk_i32 s46, 4096
    s_waitcnt vmcnt(5)
    s_cbranch_vccnz L_hik9
    s_waitcnt vmcnt(4)
L_hik9:
    buffer_load_dwordx4 v4, s[12:15], s46 offen nt lds
    s_waitcnt lgkmcnt(0)
    v_mfma_f32_16x16x32_bf16 v[160:163], v[96:99], v[28:31], 0
    v_mfma_f32_16x16x32_bf16 v[160:163], v[100:103], v[32:35], v[160:163]
    v_mfma_f32_16x16x32_bf16 v[160:163], v[104:107], v[36:39], v[160:163]
    v_mfma_f32_16x16x32_bf16 v[160:163], v[108:111], v[40:43], v[160:163]
    s_waitcnt vmcnt(5)
    s_cbranch_vccnz L_hik10
    s_waitcnt vmcnt(4)
L_hik10:
    buffer_load_dwordx4 v5, s[12:15], s46 offen offset:1024 nt lds
    s_waitcnt vmcnt(5)
    s_cbranch_vccnz L_hik11
    s_waitcnt vmcnt(4)
L_hik11:
    buffer_load_dwordx4 v6, s[12:15], s46 offen offset:2048 nt lds
    s_waitcnt vmcnt(5)
    s_cbranch_vccnz L_hik12
    s_waitcnt vmcnt(4)
L_hik12:
    buffer_load_dwordx4 v7, s[12:15], s46 offen offset:3072 nt lds
    ds_read_b128 v[96:99], v10 offset:12288
    ds_read_b128 v[100:103], v11 offset:12288
    ds_read_b128 v[104:107], v12 offset:12288
    ds_read_b128 v[108:111], v13 offset:12288
    v_max3_f32 v26, v160, v161, v26
    v_max3_f32 v26, v162, v163, v26
    s_addk_i32 m0, 0x1000
    s_addk_i32 s46, -3584
    s_waitcnt vmcnt(5)
    s_cbranch_vccnz L_hik13
    s_waitcnt vmcnt(4)
L_hik13:
    buffer_load_dwordx4 v4, s[12:15], s46 offen nt lds
    s_waitcnt lgkmcnt(0)
    v_mfma_f32_16x16x32_bf16 v[164:167], v[96:99], v[28:31], 0
    v_mfma_f32_16x16x32_bf16 v[164:167], v[100:103], v[32:35], v[164:167]
    v_mfma_f32_16x16x32_bf16 v[164:167], v[104:107], v[36:39], v[164:167]
    v_mfma_f32_16x16x32_bf16 v[164:167], v[108:111], v[40:43], v[164:167]
    s_waitcnt vmcnt(5)
    s_cbranch_vccnz L_hik14
    s_waitcnt vmcnt(4)
L_hik14:
    buffer_load_dwordx4 v5, s[12:15], s46 offen offset:1024 nt lds
    s_nop 5
    v_max3_f32 v26, v164, v165, v26
    v_max3_f32 v26, v166, v167, v26
    v_mov_b32 v27, v26
    s_nop 1
    v_permlane32_swap_b32 v27, v26
    v_max_f32 v26, v26, v27
    v_mov_b32 v27, v26
    s_nop 1
    v_permlane16_swap_b32 v27, v26
    v_max_f32 v26, v26, v27
    v_mul_f32 v26, s32, v26
    v_max_f32 v26, v26, v22
    v_sub_f32 v24, v22, v26
    v_mov_b32 v22, v26
    v_exp_f32 v24, v24
    v_pk_fma_f32 v[152:153], v[152:153], s[32:33], v[22:23] op_sel_hi:[1,0,0] neg_lo:[0,0,1] neg_hi:[0,0,1]
    v_pk_fma_f32 v[154:155], v[154:155], s[32:33], v[22:23] op_sel_hi:[1,0,0] neg_lo:[0,0,1] neg_hi:[0,0,1]
    v_pk_fma_f32 v[156:157], v[156:157], s[32:33], v[22:23] op_sel_hi:[1,0,0] neg_lo:[0,0,1] neg_hi:[0,0,1]
    v_pk_fma_f32 v[158:159], v[158:159], s[32:33], v[22:23] op_sel_hi:[1,0,0] neg_lo:[0,0,1] neg_hi:[0,0,1]
    v_pk_fma_f32 v[160:161], v[160:161], s[32:33], v[22:23] op_sel_hi:[1,0,0] neg_lo:[0,0,1] neg_hi:[0,0,1]
    v_pk_fma_f32 v[162:163], v[162:163], s[32:33], v[22:23] op_sel_hi:[1,0,0] neg_lo:[0,0,1] neg_hi:[0,0,1]
    v_pk_fma_f32 v[164:165], v[164:165], s[32:33], v[22:23] op_sel_hi:[1,0,0] neg_lo:[0,0,1] neg_hi:[0,0,1]
    v_pk_fma_f32 v[166:167], v[166:167], s[32:33], v[22:23] op_sel_hi:[1,0,0] neg_lo:[0,0,1] neg_hi:[0,0,1]
    ds_write_b32 v57, v24 offset:2048
    v_mul_f32 v60, v24, v60
    s_waitcnt vmcnt(5)
    s_cbranch_vccnz L_hik15
    s_waitcnt vmcnt(4)
L_hik15:
    buffer_load_dwordx4 v6, s[12:15], s46 offen offset:2048 nt lds
    v_exp_f32 v152, v152
    v_exp_f32 v153, v153
    v_exp_f32 v154, v154
    v_exp_f32 v155, v155
    v_exp_f32 v156, v156
    v_exp_f32 v157, v157
    v_exp_f32 v158, v158
    v_exp_f32 v159, v159
    v_exp_f32 v160, v160
    v_exp_f32 v161, v161
    v_exp_f32 v162, v162
    v_exp_f32 v163, v163
    v_exp_f32 v164, v164
    v_exp_f32 v165, v165
    v_exp_f32 v166, v166
    v_exp_f32 v167, v167
    v_cvt_pk_bf16_f32 v48, v152, v153
    v_cvt_pk_bf16_f32 v49, v154, v155
    v_cvt_pk_bf16_f32 v50, v156, v157
    v_cvt_pk_bf16_f32 v51, v158, v159
    v_cvt_pk_bf16_f32 v52, v160, v161
    v_cvt_pk_bf16_f32 v53, v162, v163
    v_cvt_pk_bf16_f32 v54, v164, v165
    v_cvt_pk_bf16_f32 v55, v166, v167
    ds_write_b128 v56, v[48:51]
    v_mfma_f32_16x16x32_bf16 v[60:63], v[44:47], v[48:51], v[60:63]
    ds_write_b128 v56, v[52:55] offset:1024
    v_mfma_f32_16x16x32_bf16 v[60:63], v[44:47], v[52:55], v[60:63]
    v_add_u32 v56, s49, v56
    v_add_u32 v57, s49, v57
    s_cmp_lg_u32 s37, 0
    s_cbranch_scc1 L_k
    v_subrev_u32 v56, 18432, v56
    v_subrev_u32 v57, 18432, v57
    s_nop 1
    v_or_b32 v23, 1, v60
    ds_write_b64 v59, v[22:23]
L_v:
    s_waitcnt vmcnt(5)
    s_cbranch_vccnz L_hiv0
    s_waitcnt vmcnt(4)
L_hiv0:
    buffer_load_dwordx4 v7, s[12:15], s46 offen offset:3072 nt lds
    v_add_u32 v8, 1, v8
    buffer_store_byte v8, v58, s[28:31], 0 offen
    buffer_load_ubyte v9, v1, s[28:31], 0 offen nt
    ds_read_b32 v24, v57 offset:4352
    ds_read_b128 v[48:51], v56
    ds_read_b128 v[52:55], v56 offset:1024
    ds_read_b64_tr_b16 v[112:113], v14 offset:0
    ds_read_b64_tr_b16 v[116:117], v15 offset:0
    ds_read_b64_tr_b16 v[120:121], v16 offset:0
    ds_read_b64_tr_b16 v[124:125], v17 offset:0
    ds_read_b64_tr_b16 v[128:129], v18 offset:0
    ds_read_b64_tr_b16 v[132:133], v19 offset:0
    ds_read_b64_tr_b16 v[136:137], v20 offset:0
    ds_read_b64_tr_b16 v[140:141], v21 offset:0
    s_addk_i32 m0, 0x1000
    s_addk_i32 s46, 4096
    s_waitcnt vmcnt(7)
    s_cbranch_vccnz L_hiv1
    s_waitcnt vmcnt(6)
L_hiv1:
    buffer_load_dwordx4 v4, s[12:15], s46 offen nt lds
    s_waitcnt vmcnt(7)
    s_cbranch_vccnz L_hiv2
    s_waitcnt vmcnt(6)
L_hiv2:
    buffer_load_dwordx4 v5, s[12:15], s46 offen offset:1024 nt lds
    s_waitcnt lgkmcnt(0)
    v_add_u32 v56, s49, v56
    v_add_u32 v57, s49, v57
    s_waitcnt vmcnt(7)
    s_cbranch_vccnz L_hiv3
    s_waitcnt vmcnt(6)
L_hiv3:
    buffer_load_dwordx4 v6, s[12:15], s46 offen offset:2048 nt lds
    s_waitcnt vmcnt(7)
    s_cbranch_vccnz L_hiv4
    s_waitcnt vmcnt(6)
L_hiv4:
    buffer_load_dwordx4 v7, s[12:15], s46 offen offset:3072 nt lds
    ds_read_b64_tr_b16 v[114:115], v14 offset:4096
    ds_read_b64_tr_b16 v[118:119], v15 offset:4096
    ds_read_b64_tr_b16 v[122:123], v16 offset:4096
    ds_read_b64_tr_b16 v[126:127], v17 offset:4096
    ds_read_b64_tr_b16 v[130:131], v18 offset:4096
    ds_read_b64_tr_b16 v[134:135], v19 offset:4096
    ds_read_b64_tr_b16 v[138:139], v20 offset:4096
    ds_read_b64_tr_b16 v[142:143], v21 offset:4096
    s_sub_u32 s37, s37, s48
    s_and_b32 s37, s37, s48
    s_xor_b32 s46, s37, s36
    s_mov_b32 m0, s19
    s_waitcnt vmcnt(7)
    s_cbranch_vccnz L_hiv5
    s_waitcnt vmcnt(6)
L_hiv5:
    buffer_load_dwordx4 v4, s[12:15], s46 offen nt lds
    s_waitcnt lgkmcnt(0)
    v_mfma_f32_16x16x32_bf16 v[64:67], v[112:115], v[48:51], v[64:67]
    v_mfma_f32_16x16x32_bf16 v[68:71], v[116:119], v[48:51], v[68:71]
    v_mfma_f32_16x16x32_bf16 v[72:75], v[120:123], v[48:51], v[72:75]
    v_mfma_f32_16x16x32_bf16 v[76:79], v[124:127], v[48:51], v[76:79]
    v_mfma_f32_16x16x32_bf16 v[80:83], v[128:131], v[48:51], v[80:83]
    v_mfma_f32_16x16x32_bf16 v[84:87], v[132:135], v[48:51], v[84:87]
    v_mfma_f32_16x16x32_bf16 v[88:91], v[136:139], v[48:51], v[88:91]
    v_mfma_f32_16x16x32_bf16 v[92:95], v[140:143], v[48:51], v[92:95]
    s_waitcnt vmcnt(7)
    s_cbranch_vccnz L_hiv6
    s_waitcnt vmcnt(4)
L_hiv6:
    buffer_load_dwordx4 v5, s[12:15], s46 offen offset:1024 nt lds
    s_waitcnt vmcnt(5)
    s_cbranch_vccnz L_hiv7
    s_waitcnt vmcnt(4)
L_hiv7:
    buffer_load_dwordx4 v6, s[12:15], s46 offen offset:2048 nt lds
    v_cmp_le_u32 vcc, v8, v9
    s_bcnt1_i32_b64 s39, vcc
    s_cmp_ge_u32 s39, s38
    s_cselect_b64 vcc, -1, 0
    s_waitcnt vmcnt(5)
    s_cbranch_vccnz L_hiv8
    s_waitcnt vmcnt(4)
L_hiv8:
    buffer_load_dwordx4 v7, s[12:15], s46 offen offset:3072 nt lds
    ds_read_b64_tr_b16 v[112:113], v14 offset:8192
    ds_read_b64_tr_b16 v[116:117], v15 offset:8192
    ds_read_b64_tr_b16 v[120:121], v16 offset:8192
    ds_read_b64_tr_b16 v[124:125], v17 offset:8192
    ds_read_b64_tr_b16 v[128:129], v18 offset:8192
    ds_read_b64_tr_b16 v[132:133], v19 offset:8192
    ds_read_b64_tr_b16 v[136:137], v20 offset:8192
    ds_read_b64_tr_b16 v[140:141], v21 offset:8192
    s_addk_i32 m0, 0x1000
    s_addk_i32 s46, 4096
    s_waitcnt vmcnt(5)
    s_cbranch_vccnz L_hiv9
    s_waitcnt vmcnt(4)
L_hiv9:
    buffer_load_dwordx4 v4, s[12:15], s46 offen nt lds
    s_waitcnt lgkmcnt(0)
    s_waitcnt vmcnt(5)
    s_cbranch_vccnz L_hiv10
    s_waitcnt vmcnt(4)
L_hiv10:
    buffer_load_dwordx4 v5, s[12:15], s46 offen offset:1024 nt lds
    s_waitcnt vmcnt(5)
    s_cbranch_vccnz L_hiv11
    s_waitcnt vmcnt(4)
L_hiv11:
    buffer_load_dwordx4 v6, s[12:15], s46 offen offset:2048 nt lds
    s_waitcnt vmcnt(5)
    s_cbranch_vccnz L_hiv12
    s_waitcnt vmcnt(4)
L_hiv12:
    buffer_load_dwordx4 v7, s[12:15], s46 offen offset:3072 nt lds
    ds_read_b64_tr_b16 v[114:115], v14 offset:12288
    ds_read_b64_tr_b16 v[118:119], v15 offset:12288
    ds_read_b64_tr_b16 v[122:123], v16 offset:12288
    ds_read_b64_tr_b16 v[126:127], v17 offset:12288
    ds_read_b64_tr_b16 v[130:131], v18 offset:12288
    ds_read_b64_tr_b16 v[134:135], v19 offset:12288
    ds_read_b64_tr_b16 v[138:139], v20 offset:12288
    ds_read_b64_tr_b16 v[142:143], v21 offset:12288
    s_addk_i32 m0, 0x1000
    s_addk_i32 s46, -3584
    s_waitcnt vmcnt(5)
    s_cbranch_vccnz L_hiv13
    s_waitcnt vmcnt(4)
L_hiv13:
    buffer_load_dwordx4 v4, s[12:15], s46 offen nt lds
    s_waitcnt lgkmcnt(0)
    v_mfma_f32_16x16x32_bf16 v[64:67], v[112:115], v[52:55], v[64:67]
    v_mfma_f32_16x16x32_bf16 v[68:71], v[116:119], v[52:55], v[68:71]
    v_mfma_f32_16x16x32_bf16 v[72:75], v[120:123], v[52:55], v[72:75]
    v_mfma_f32_16x16x32_bf16 v[76:79], v[124:127], v[52:55], v[76:79]
    v_mfma_f32_16x16x32_bf16 v[80:83], v[128:131], v[52:55], v[80:83]
    v_mfma_f32_16x16x32_bf16 v[84:87], v[132:135], v[52:55], v[84:87]
    v_mfma_f32_16x16x32_bf16 v[88:91], v[136:139], v[52:55], v[88:91]
    v_mfma_f32_16x16x32_bf16 v[92:95], v[140:143], v[52:55], v[92:95]
    s_waitcnt vmcnt(5)
    s_cbranch_vccnz L_hiv14
    s_waitcnt vmcnt(4)
L_hiv14:
    buffer_load_dwordx4 v5, s[12:15], s46 offen offset:1024 nt lds
    s_cmp_eq_u32 s37, s48
    v_pk_mul_f32 v[64:65], v[64:65], v[24:25] op_sel_hi:[1,0]
    v_pk_mul_f32 v[66:67], v[66:67], v[24:25] op_sel_hi:[1,0]
    v_pk_mul_f32 v[68:69], v[68:69], v[24:25] op_sel_hi:[1,0]
    v_pk_mul_f32 v[70:71], v[70:71], v[24:25] op_sel_hi:[1,0]
    v_pk_mul_f32 v[72:73], v[72:73], v[24:25] op_sel_hi:[1,0]
    v_pk_mul_f32 v[74:75], v[74:75], v[24:25] op_sel_hi:[1,0]
    v_pk_mul_f32 v[76:77], v[76:77], v[24:25] op_sel_hi:[1,0]
    v_pk_mul_f32 v[78:79], v[78:79], v[24:25] op_sel_hi:[1,0]
    v_pk_mul_f32 v[80:81], v[80:81], v[24:25] op_sel_hi:[1,0]
    v_pk_mul_f32 v[82:83], v[82:83], v[24:25] op_sel_hi:[1,0]
    v_pk_mul_f32 v[84:85], v[84:85], v[24:25] op_sel_hi:[1,0]
    v_pk_mul_f32 v[86:87], v[86:87], v[24:25] op_sel_hi:[1,0]
    v_pk_mul_f32 v[88:89], v[88:89], v[24:25] op_sel_hi:[1,0]
    v_pk_mul_f32 v[90:91], v[90:91], v[24:25] op_sel_hi:[1,0]
    v_pk_mul_f32 v[92:93], v[92:93], v[24:25] op_sel_hi:[1,0]
    v_pk_mul_f32 v[94:95], v[94:95], v[24:25] op_sel_hi:[1,0]
    s_cbranch_scc1 L_last
    s_waitcnt vmcnt(5)
    s_cbranch_vccnz L_hiv15
    s_waitcnt vmcnt(4)
L_hiv15:
    buffer_load_dwordx4 v6, s[12:15], s46 offen offset:2048 nt lds
    s_branch L_v
L_last:
    buffer_load_dwordx4 v6, s[12:15], s46 offen offset:2048 nt lds
    buffer_load_dwordx4 v7, s[12:15], s46 offen offset:3072 nt lds
    s_addk_i32 m0, 0x1000
    s_addk_i32 s46, 4096
    buffer_load_dwordx4 v4, s[12:15], s46 offen nt lds
    buffer_load_dwordx4 v5, s[12:15], s46 offen offset:1024 nt lds
    buffer_load_dwordx4 v6, s[12:15], s46 offen offset:2048 nt lds
    buffer_load_dwordx4 v7, s[12:15], s46 offen offset:3072 nt lds
    v_and_b32 v147, 0xfffffe7f, v59
L_poll:
    ds_read2_b64 v[28:31], v147 offset0:0 offset1:16
    ds_read2_b64 v[32:35], v147 offset0:32 offset1:48
    v_lshlrev_b32 v146, 3, v1
    v_lshl_add_u32 v145, s33, 10, v146
    v_lshlrev_b32 v144, 4, v1
    v_add_u32 v56, s50, v144
    v_add_u32 v144, 69632, v144
    v_add_u32 v149, 16128, v144
    v_lshl_add_u32 v144, s33, 11, v144
    s_mul_i32 s34, s33, 0x4040
    v_xor_b32 v10, s34, v14
    v_xor_b32 v11, s34, v15
    s_waitcnt lgkmcnt(0)
    v_min3_u32 v26, v29, v31, v33
    v_min_u32 v26, v26, v35
    v_cmp_eq_u32 vcc, 0, v26
    s_cbranch_vccnz L_poll
    ds_write_b128 v56, v[64:67] offset:0
    v_max3_f32 v26, v28, v30, v32
    v_max_f32 v26, v26, v34
    v_sub_f32 v36, v22, v26
    ds_write_b128 v56, v[68:71] offset:1024
    v_sub_f32 v40, v28, v26
    v_sub_f32 v41, v30, v26
    v_sub_f32 v42, v32, v26
    ds_write_b128 v56, v[72:75] offset:2048
    v_sub_f32 v43, v34, v26
    v_exp_f32 v40, v40
    v_exp_f32 v41, v41
    ds_write_b128 v56, v[76:79] offset:3072
    v_exp_f32 v42, v42
    v_exp_f32 v43, v43
    v_exp_f32 v36, v36
    ds_write_b128 v56, v[80:83] offset:4096
    v_mul_f32 v27, v40, v29
    v_fmac_f32 v27, v41, v31
    v_fmac_f32 v27, v42, v33
    ds_write_b128 v56, v[84:87] offset:5120
    v_fmac_f32 v27, v43, v35
    v_rcp_f32 v27, v27
    s_lshl_b32 s34, s33, 6
    ds_write_b128 v56, v[88:91] offset:6144
    v_mul_f32 v36, v36, v27
    v_pk_mul_f32 v[160:161], v[160:161], v[36:37] op_sel_hi:[1,0]
    v_pk_mul_f32 v[162:163], v[162:163], v[36:37] op_sel_hi:[1,0]
    ds_write_b128 v56, v[92:95] offset:7168
    v_pk_mul_f32 v[164:165], v[164:165], v[36:37] op_sel_hi:[1,0]
    v_pk_mul_f32 v[166:167], v[166:167], v[36:37] op_sel_hi:[1,0]
    v_cvt_pk_bf16_f32 v52, v160, v161
    v_cvt_pk_bf16_f32 v53, v162, v163
    v_cvt_pk_bf16_f32 v54, v164, v165
    v_cvt_pk_bf16_f32 v55, v166, v167
    ds_write2st64_b64 v145, v[52:53], v[54:55] offset1:1
    ds_read_b128 v[168:171], v149 offset:0
    ds_read_b128 v[172:175], v149 offset:18432
    ds_read_b128 v[176:179], v149 offset:36864
    ds_read_b128 v[180:183], v149 offset:55296
    v_mul_f32 v40, v40, v27
    v_mul_f32 v41, v41, v27
    v_mul_f32 v42, v42, v27
    v_mul_f32 v43, v43, v27
    s_waitcnt vmcnt(12) lgkmcnt(4)
    s_barrier
    ds_read_b128 v[64:67], v144 offset:0
    ds_read_b128 v[68:71], v144 offset:1024
    ds_read_b128 v[72:75], v144 offset:18432
    ds_read_b128 v[76:79], v144 offset:19456
    ds_read_b128 v[80:83], v144 offset:36864
    ds_read_b128 v[84:87], v144 offset:37888
    ds_read_b128 v[88:91], v144 offset:55296
    ds_read_b128 v[92:95], v144 offset:56320
    s_waitcnt lgkmcnt(7)
    ds_read_b64_tr_b16 v[112:113], v10 offset:0
    ds_read_b64_tr_b16 v[116:117], v11 offset:0
    ds_read_b64_tr_b16 v[120:121], v10 offset:16384
    ds_read_b64_tr_b16 v[124:125], v11 offset:16384
    ds_read_b64_tr_b16 v[128:129], v10 offset:32768
    ds_read_b64_tr_b16 v[132:133], v11 offset:32768
    ds_read_b64_tr_b16 v[136:137], v10 offset:49152
    ds_read_b64_tr_b16 v[140:141], v11 offset:49152
    s_waitcnt vmcnt(8) lgkmcnt(3)
    s_barrier
    ds_read_b64_tr_b16 v[114:115], v10 offset:4096
    ds_read_b64_tr_b16 v[118:119], v11 offset:4096
    ds_read_b64_tr_b16 v[122:123], v10 offset:20480
    ds_read_b64_tr_b16 v[126:127], v11 offset:20480
    ds_read_b64_tr_b16 v[130:131], v10 offset:36864
    ds_read_b64_tr_b16 v[134:135], v11 offset:36864
    ds_read_b64_tr_b16 v[138:139], v10 offset:53248
    ds_read_b64_tr_b16 v[142:143], v11 offset:53248
    ds_read2st64_b64 v[96:99], v146 offset0:0 offset1:2
    ds_read2st64_b64 v[100:103], v146 offset0:4 offset1:6
    ds_read2st64_b64 v[104:107], v146 offset0:1 offset1:3
    ds_read2st64_b64 v[108:111], v146 offset0:5 offset1:7
    v_lshrrev_b32 v26, 2, v1
    v_add_u32 v13, v26, v1
    v_lshl_add_u32 v13, v13, 4, s50
    v_mad_u32_u24 v12, v3, 10, v2
    v_lshl_add_u32 v12, v12, 3, s50
    v_mul_u32_u24 v26, 12, v26
    v_add_lshl_u32 v148, v26, v1, 4
    s_waitcnt lgkmcnt(4)
    v_mfma_f32_16x16x32_bf16 v[64:67], v[112:115], v[168:171], v[64:67]
    v_mfma_f32_16x16x32_bf16 v[68:71], v[116:119], v[168:171], v[68:71]
    v_mfma_f32_16x16x32_bf16 v[72:75], v[120:123], v[172:175], v[72:75]
    v_mfma_f32_16x16x32_bf16 v[76:79], v[124:127], v[172:175], v[76:79]
    v_mfma_f32_16x16x32_bf16 v[80:83], v[128:131], v[176:179], v[80:83]
    v_mfma_f32_16x16x32_bf16 v[84:87], v[132:135], v[176:179], v[84:87]
    v_mfma_f32_16x16x32_bf16 v[88:91], v[136:139], v[180:183], v[88:91]
    v_mfma_f32_16x16x32_bf16 v[92:95], v[140:143], v[180:183], v[92:95]
    s_nop 0
    v_pk_mul_f32 v[48:49], v[64:65], v[40:41] op_sel_hi:[1,0]
    v_pk_mul_f32 v[50:51], v[66:67], v[40:41] op_sel_hi:[1,0]
    v_pk_mul_f32 v[52:53], v[68:69], v[40:41] op_sel_hi:[1,0]
    v_pk_mul_f32 v[54:55], v[70:71], v[40:41] op_sel_hi:[1,0]
    v_pk_fma_f32 v[48:49], v[72:73], v[40:41], v[48:49] op_sel:[0,1,0] op_sel_hi:[1,1,1]
    v_pk_fma_f32 v[50:51], v[74:75], v[40:41], v[50:51] op_sel:[0,1,0] op_sel_hi:[1,1,1]
    v_pk_fma_f32 v[52:53], v[76:77], v[40:41], v[52:53] op_sel:[0,1,0] op_sel_hi:[1,1,1]
    v_pk_fma_f32 v[54:55], v[78:79], v[40:41], v[54:55] op_sel:[0,1,0] op_sel_hi:[1,1,1]
    v_pk_fma_f32 v[48:49], v[80:81], v[42:43], v[48:49] op_sel_hi:[1,0,1]
    v_pk_fma_f32 v[50:51], v[82:83], v[42:43], v[50:51] op_sel_hi:[1,0,1]
    v_pk_fma_f32 v[52:53], v[84:85], v[42:43], v[52:53] op_sel_hi:[1,0,1]
    v_pk_fma_f32 v[54:55], v[86:87], v[42:43], v[54:55] op_sel_hi:[1,0,1]
    v_pk_fma_f32 v[48:49], v[88:89], v[42:43], v[48:49] op_sel:[0,1,0] op_sel_hi:[1,1,1]
    v_pk_fma_f32 v[50:51], v[90:91], v[42:43], v[50:51] op_sel:[0,1,0] op_sel_hi:[1,1,1]
    v_pk_fma_f32 v[52:53], v[92:93], v[42:43], v[52:53] op_sel:[0,1,0] op_sel_hi:[1,1,1]
    v_pk_fma_f32 v[54:55], v[94:95], v[42:43], v[54:55] op_sel:[0,1,0] op_sel_hi:[1,1,1]
    s_waitcnt vmcnt(4) lgkmcnt(0)
    s_barrier
    ds_read_b64_tr_b16 v[184:185], v10 offset:8192
    ds_read_b64_tr_b16 v[186:187], v10 offset:24576
    ds_read_b64_tr_b16 v[188:189], v11 offset:8192
    ds_read_b64_tr_b16 v[190:191], v11 offset:24576
    ds_read_b64_tr_b16 v[192:193], v10 offset:40960
    ds_read_b64_tr_b16 v[194:195], v10 offset:57344
    ds_read_b64_tr_b16 v[196:197], v11 offset:40960
    ds_read_b64_tr_b16 v[198:199], v11 offset:57344
    s_waitcnt vmcnt(0) lgkmcnt(7)
    s_barrier
    ds_read_b64_tr_b16 v[112:113], v10 offset:12288
    ds_read_b64_tr_b16 v[114:115], v10 offset:28672
    ds_read_b64_tr_b16 v[116:117], v11 offset:12288
    ds_read_b64_tr_b16 v[118:119], v11 offset:28672
    ds_read_b64_tr_b16 v[120:121], v10 offset:45056
    ds_read_b64_tr_b16 v[122:123], v10 offset:61440
    ds_read_b64_tr_b16 v[124:125], v11 offset:45056
    ds_read_b64_tr_b16 v[126:127], v11 offset:61440
    s_waitcnt lgkmcnt(8)
    v_mfma_f32_16x16x32_bf16 v[48:51], v[184:187], v[96:99], v[48:51]
    v_mfma_f32_16x16x32_bf16 v[52:55], v[188:191], v[96:99], v[52:55]
    v_mfma_f32_16x16x32_bf16 v[48:51], v[192:195], v[100:103], v[48:51]
    v_mfma_f32_16x16x32_bf16 v[52:55], v[196:199], v[100:103], v[52:55]
    s_waitcnt lgkmcnt(6)
    v_mfma_f32_16x16x32_bf16 v[48:51], v[112:115], v[104:107], v[48:51]
    s_waitcnt lgkmcnt(4)
    v_mfma_f32_16x16x32_bf16 v[52:55], v[116:119], v[104:107], v[52:55]
    s_waitcnt lgkmcnt(2)
    v_mfma_f32_16x16x32_bf16 v[48:51], v[120:123], v[108:111], v[48:51]
    s_waitcnt lgkmcnt(0)
    v_mfma_f32_16x16x32_bf16 v[52:55], v[124:127], v[108:111], v[52:55]
    s_nop 5
    v_cvt_pk_bf16_f32 v56, v48, v49
    v_cvt_pk_bf16_f32 v57, v50, v51
    v_cvt_pk_bf16_f32 v58, v52, v53
    v_cvt_pk_bf16_f32 v59, v54, v55
    ds_write2_b64 v12, v[56:57], v[58:59] offset1:4
    ds_read_b128 v[56:59], v13
    s_waitcnt lgkmcnt(0)
    buffer_store_dwordx4 v[56:59], v148, s[24:27], s34 offen
L_end:
    s_endpgm
.section .rodata,"a"
.p2align 6
.amdhsa_kernel standalone__gqa_softmax__sampling_kernel
  .amdhsa_next_free_vgpr 200
  .amdhsa_next_free_sgpr 64
  .amdhsa_accum_offset 200
  .amdhsa_group_segment_fixed_size 0
  .amdhsa_kernarg_size 48
  .amdhsa_user_sgpr_count 2
  .amdhsa_user_sgpr_kernarg_segment_ptr 1
  .amdhsa_system_sgpr_workgroup_id_x 1
  .amdhsa_float_denorm_mode_32 3
.end_amdhsa_kernel
```
